```python
import torch

def _softmax(x, axis=-1):
    return torch.softmax(x, dim=axis)
def _gelu(x):
    return torch.nn.functional.gelu(x, approximate="tanh")
def _silu(x):
    return torch.nn.functional.silu(x)
def _sigmoid(x):
    return torch.sigmoid(x)
def _layernorm(x, axis=-1, eps=1e-5):
    m = x.mean(dim=axis, keepdim=True)
    v = x.var(dim=axis, keepdim=True, unbiased=False)
    return (x - m) / torch.sqrt(v + eps)
def _scatter_add(tgt, idx, src, axis=0):
    return tgt.clone().index_add_(axis, idx, src)
def _segment_sum(src, seg, n):
    out = torch.zeros((n,) + src.shape[1:], dtype=src.dtype)
    return out.index_add_(0, seg, src)
def _pad(x, pw):
    flat = tuple(v for pair in reversed(pw) for v in pair)
    return torch.nn.functional.pad(x, flat)

kernel_name = 'standalone__mha_block_cached__near_ridge'

def setup_inputs():

    _w = (lambda a: (lambda t: t.to(torch.bfloat16) if t.is_floating_point() else t)(torch.as_tensor(a)))
    B, Sq, D = 8, 64, 1024
    H, Sk, Dh = 32, 64, 128
    return {
        "x": _w((lambda *s: torch.randn(*s, dtype=torch.bfloat16) * 0.8)(B, Sq, D)),
        "k_cache": _w((lambda *s: torch.randn(*s, dtype=torch.bfloat16) * 0.8)(B, H, Sk, Dh)),
        "v_cache": _w((lambda *s: torch.randn(*s, dtype=torch.bfloat16) * 0.05)(B, H, Sk, Dh)),
        "wq": _w((lambda *s: torch.randn(*s, dtype=torch.bfloat16) * 0.8)(D, H * Dh) * (D ** -0.5)),
        "wo": _w((lambda *s: torch.randn(*s, dtype=torch.bfloat16) * 0.05)(H * Dh, D) * ((H * Dh) ** -0.5)),
    }

def reference(x, k_cache, v_cache, wq, wo):
    B, Sq, D = x.shape
    H, Dh = 32, 128
    q = (lambda x, *d: x.permute(*d))((x @ wq).reshape(B, Sq, H, Dh), 0, 2, 1, 3)
    scores = torch.einsum("bhqd,bhkd->bhqk", q, k_cache) * (Dh ** -0.5)
    p = _softmax(scores, axis=-1)
    o = torch.einsum("bhqk,bhkd->bhqd", p, v_cache)
    return (lambda x, *d: x.permute(*d))(o, 0, 2, 1, 3).reshape(B, Sq, H * Dh) @ wo
```

```asm
; @launch kernel=mha_k1_kernel grid=(256,1,1) block=(512,1,1) lds=155648
; @launch kernel=mha_k2_kernel grid=(256,1,1) block=(512,1,1) lds=147456
.amdgcn_target "amdgcn-amd-amdhsa--gfx950"
.text
.globl mha_k1_kernel
.p2align 8
.type mha_k1_kernel,@function
mha_k1_kernel:
    s_cmp_ge_u32 s2, 256
    s_cbranch_scc1 mha_k1_kernel_end
    s_load_dwordx16 s[16:31], s[0:1], 0
    v_lshrrev_b32 v1, 6, v0
    v_and_b32 v0, 63, v0
    s_and_b32 s4, s2, 7
    v_readfirstlane_b32 s3, v1
    s_lshr_b32 s5, s2, 3
    s_and_b32 s5, s5, 3
    s_lshr_b32 s6, s2, 5
    s_lshl_b32 s7, s4, 2
    s_add_u32 s7, s7, s5
    s_lshl_b32 s56, s6, 17
    s_lshl_b32 s57, s7, 8
    s_lshl_b32 s9, s6, 1
    s_lshl_b32 s10, s5, 2
    s_add_u32 s9, s9, s10
    s_and_b32 s9, s9, 15
    s_waitcnt lgkmcnt(0)
    s_mov_b32 s32, s16
    s_mov_b32 s33, s17
    s_mov_b32 s34, 0x100000
    s_mov_b32 s35, 0x00020000
    s_mov_b32 s36, s22
    s_mov_b32 s37, s23
    s_mov_b32 s38, 0x800000
    s_mov_b32 s39, 0x00020000
    s_mov_b32 s40, s18
    s_mov_b32 s41, s19
    s_mov_b32 s42, 0x400000
    s_mov_b32 s43, 0x00020000
    s_mov_b32 s44, s20
    s_mov_b32 s45, s21
    s_mov_b32 s46, 0x400000
    s_mov_b32 s47, 0x00020000
    s_mov_b32 s48, s30
    s_mov_b32 s49, s31
    s_mov_b32 s50, 0x2000000
    s_mov_b32 s51, 0x00020000
    s_mov_b32 s92, s24
    s_mov_b32 s93, s25
    s_mov_b32 s94, 0x800000
    s_mov_b32 s95, 0x00020000
    s_cmp_ge_u32 s3, 4
    s_cbranch_scc1 mha_k1_kernel_prod
    v_and_b32 v1, 31, v0
    v_lshrrev_b32 v2, 5, v0
    v_and_b32 v3, 15, v0
    v_lshrrev_b32 v4, 4, v0
    v_and_b32 v5, 1, v4
    v_lshrrev_b32 v6, 2, v3
    v_and_b32 v7, 3, v3
    s_and_b32 s10, s3, 1
    s_lshr_b32 s11, s3, 1
    s_cmp_lg_u32 s3, 0
    s_cbranch_scc1 mha_k1_kernel_nozero
    s_cmp_ge_u32 s2, 64
    s_cbranch_scc1 mha_k1_kernel_nozero
    s_lshl_b32 s52, s2, 8
    s_add_u32 s52, s52, 0x1000000
    v_lshlrev_b32 v8, 2, v0
    v_mov_b32 v9, 0
    buffer_store_dword v9, v8, s[48:51], s52 offen
mha_k1_kernel_nozero:
    v_bfe_u32 v8, v1, 1, 3
    v_xor_b32 v8, v2, v8
    v_lshlrev_b32 v8, 4, v8
    v_lshlrev_b32 v9, 7, v1
    s_lshl_b32 s12, s11, 12
    s_add_u32 s12, s12, 0
    v_add_u32 v9, s12, v9
    v_add_u32 v16, v9, v8
    v_xor_b32 v17, 32, v16
    v_xor_b32 v18, 64, v16
    v_xor_b32 v19, 0x60, v16
    s_lshl_b32 s13, s10, 1
    v_xor_b32 v10, s13, v6
    v_lshlrev_b32 v10, 6, v10
    v_lshlrev_b32 v11, 11, v2
    v_lshl_add_u32 v11, v6, 8, v11
    v_add_u32 v10, v10, v11
    v_lshl_add_u32 v10, v5, 5, v10
    v_lshl_add_u32 v10, v7, 3, v10
    v_add_u32 v20, 8192, v10
    v_xor_b32 v21, 64, v20
    v_mov_b32 v24, 0
    v_mov_b32 v25, 0
    v_mov_b32 v26, 0
    v_mov_b32 v27, 0
    v_mov_b32 v28, 0
    v_mov_b32 v29, 0
    v_mov_b32 v30, 0
    v_mov_b32 v31, 0
    v_mov_b32 v32, 0
    v_mov_b32 v33, 0
    v_mov_b32 v34, 0
    v_mov_b32 v35, 0
    v_mov_b32 v36, 0
    v_mov_b32 v37, 0
    v_mov_b32 v38, 0
    v_mov_b32 v39, 0
    v_mov_b32 v40, 0
    v_mov_b32 v41, 0
    v_mov_b32 v42, 0
    v_mov_b32 v43, 0
    v_mov_b32 v44, 0
    v_mov_b32 v45, 0
    v_mov_b32 v46, 0
    v_mov_b32 v47, 0
    v_mov_b32 v48, 0
    v_mov_b32 v49, 0
    v_mov_b32 v50, 0
    v_mov_b32 v51, 0
    v_mov_b32 v52, 0
    v_mov_b32 v53, 0
    v_mov_b32 v54, 0
    v_mov_b32 v55, 0
    v_mov_b32 v104, 0
    v_mov_b32 v105, 0
    v_mov_b32 v106, 0
    v_mov_b32 v107, 0
    v_mov_b32 v108, 0
    v_mov_b32 v109, 0
    v_mov_b32 v110, 0
    v_mov_b32 v111, 0
    v_mov_b32 v112, 0
    v_mov_b32 v113, 0
    v_mov_b32 v114, 0
    v_mov_b32 v115, 0
    v_mov_b32 v116, 0
    v_mov_b32 v117, 0
    v_mov_b32 v118, 0
    v_mov_b32 v119, 0
    v_mov_b32 v120, 0
    v_mov_b32 v121, 0
    v_mov_b32 v122, 0
    v_mov_b32 v123, 0
    v_mov_b32 v124, 0
    v_mov_b32 v125, 0
    v_mov_b32 v126, 0
    v_mov_b32 v127, 0
    v_mov_b32 v128, 0
    v_mov_b32 v129, 0
    v_mov_b32 v130, 0
    v_mov_b32 v131, 0
    v_mov_b32 v132, 0
    v_mov_b32 v133, 0
    v_mov_b32 v134, 0
    v_mov_b32 v135, 0
    v_mov_b32 v136, 0
    v_mov_b32 v137, 0
    v_mov_b32 v138, 0
    v_mov_b32 v139, 0
    v_mov_b32 v140, 0
    v_mov_b32 v141, 0
    v_mov_b32 v142, 0
    v_mov_b32 v143, 0
    v_mov_b32 v144, 0
    v_mov_b32 v145, 0
    v_mov_b32 v146, 0
    v_mov_b32 v147, 0
    v_mov_b32 v148, 0
    v_mov_b32 v149, 0
    v_mov_b32 v150, 0
    v_mov_b32 v151, 0
    s_mov_b32 s60, 0
    s_mov_b32 s61, 0
    s_mov_b32 s62, 24576
    s_mov_b32 s63, 4294868992
mha_k1_kernel_cons:
    s_barrier
    ds_read_b128 v[64:67], v16
    ds_read_b64_tr_b16 v[56:57], v20 offset:0
    ds_read_b64_tr_b16 v[58:59], v20 offset:1024
    ds_read_b64_tr_b16 v[60:61], v21 offset:0
    ds_read_b64_tr_b16 v[62:63], v21 offset:1024
    v_mfma_f32_32x32x16_bf16 v[24:39], v[104:107], v[112:115], v[24:39]
    v_mfma_f32_32x32x16_bf16 v[40:55], v[108:111], v[112:115], v[40:55]
    ds_read_b128 v[76:79], v17
    ds_read_b64_tr_b16 v[68:69], v20 offset:4096
    ds_read_b64_tr_b16 v[70:71], v20 offset:5120
    ds_read_b64_tr_b16 v[72:73], v21 offset:4096
    ds_read_b64_tr_b16 v[74:75], v21 offset:5120
    v_mfma_f32_32x32x16_bf16 v[24:39], v[116:119], v[124:127], v[24:39]
    v_mfma_f32_32x32x16_bf16 v[40:55], v[120:123], v[124:127], v[40:55]
    ds_read_b128 v[88:91], v18
    ds_read_b64_tr_b16 v[80:81], v20 offset:8192
    ds_read_b64_tr_b16 v[82:83], v20 offset:9216
    ds_read_b64_tr_b16 v[84:85], v21 offset:8192
    ds_read_b64_tr_b16 v[86:87], v21 offset:9216
    v_mfma_f32_32x32x16_bf16 v[24:39], v[128:131], v[136:139], v[24:39]
    v_mfma_f32_32x32x16_bf16 v[40:55], v[132:135], v[136:139], v[40:55]
    ds_read_b128 v[100:103], v19
    ds_read_b64_tr_b16 v[92:93], v20 offset:12288
    ds_read_b64_tr_b16 v[94:95], v20 offset:13312
    ds_read_b64_tr_b16 v[96:97], v21 offset:12288
    ds_read_b64_tr_b16 v[98:99], v21 offset:13312
    v_mfma_f32_32x32x16_bf16 v[24:39], v[140:143], v[148:151], v[24:39]
    v_mfma_f32_32x32x16_bf16 v[40:55], v[144:147], v[148:151], v[40:55]
    s_add_u32 s60, s60, 1
    s_cmp_eq_u32 s60, 5
    s_cselect_b32 s59, s63, s62
    s_cselect_b32 s60, 0, s60
    v_add_u32 v16, s59, v16
    v_add_u32 v17, s59, v17
    v_add_u32 v18, s59, v18
    v_add_u32 v19, s59, v19
    v_add_u32 v20, s59, v20
    v_add_u32 v21, s59, v21
    s_waitcnt lgkmcnt(0)
    s_barrier
    ds_read_b128 v[112:115], v16
    ds_read_b64_tr_b16 v[104:105], v20 offset:0
    ds_read_b64_tr_b16 v[106:107], v20 offset:1024
    ds_read_b64_tr_b16 v[108:109], v21 offset:0
    ds_read_b64_tr_b16 v[110:111], v21 offset:1024
    v_mfma_f32_32x32x16_bf16 v[24:39], v[56:59], v[64:67], v[24:39]
    v_mfma_f32_32x32x16_bf16 v[40:55], v[60:63], v[64:67], v[40:55]
    ds_read_b128 v[124:127], v17
    ds_read_b64_tr_b16 v[116:117], v20 offset:4096
    ds_read_b64_tr_b16 v[118:119], v20 offset:5120
    ds_read_b64_tr_b16 v[120:121], v21 offset:4096
    ds_read_b64_tr_b16 v[122:123], v21 offset:5120
    v_mfma_f32_32x32x16_bf16 v[24:39], v[68:71], v[76:79], v[24:39]
    v_mfma_f32_32x32x16_bf16 v[40:55], v[72:75], v[76:79], v[40:55]
    ds_read_b128 v[136:139], v18
    ds_read_b64_tr_b16 v[128:129], v20 offset:8192
    ds_read_b64_tr_b16 v[130:131], v20 offset:9216
    ds_read_b64_tr_b16 v[132:133], v21 offset:8192
    ds_read_b64_tr_b16 v[134:135], v21 offset:9216
    v_mfma_f32_32x32x16_bf16 v[24:39], v[80:83], v[88:91], v[24:39]
    v_mfma_f32_32x32x16_bf16 v[40:55], v[84:87], v[88:91], v[40:55]
    ds_read_b128 v[148:151], v19
    ds_read_b64_tr_b16 v[140:141], v20 offset:12288
    ds_read_b64_tr_b16 v[142:143], v20 offset:13312
    ds_read_b64_tr_b16 v[144:145], v21 offset:12288
    ds_read_b64_tr_b16 v[146:147], v21 offset:13312
    v_mfma_f32_32x32x16_bf16 v[24:39], v[92:95], v[100:103], v[24:39]
    v_mfma_f32_32x32x16_bf16 v[40:55], v[96:99], v[100:103], v[40:55]
    s_add_u32 s60, s60, 1
    s_cmp_eq_u32 s60, 5
    s_cselect_b32 s59, s63, s62
    s_cselect_b32 s60, 0, s60
    v_add_u32 v16, s59, v16
    v_add_u32 v17, s59, v17
    v_add_u32 v18, s59, v18
    v_add_u32 v19, s59, v19
    v_add_u32 v20, s59, v20
    v_add_u32 v21, s59, v21
    s_waitcnt lgkmcnt(0)
    s_add_u32 s61, s61, 2
    s_cmp_lt_u32 s61, 16
    s_cbranch_scc1 mha_k1_kernel_cons
    v_mfma_f32_32x32x16_bf16 v[24:39], v[104:107], v[112:115], v[24:39]
    v_mfma_f32_32x32x16_bf16 v[40:55], v[108:111], v[112:115], v[40:55]
    v_mfma_f32_32x32x16_bf16 v[24:39], v[116:119], v[124:127], v[24:39]
    v_mfma_f32_32x32x16_bf16 v[40:55], v[120:123], v[124:127], v[40:55]
    v_mfma_f32_32x32x16_bf16 v[24:39], v[128:131], v[136:139], v[24:39]
    v_mfma_f32_32x32x16_bf16 v[40:55], v[132:135], v[136:139], v[40:55]
    v_mfma_f32_32x32x16_bf16 v[24:39], v[140:143], v[148:151], v[24:39]
    v_mfma_f32_32x32x16_bf16 v[40:55], v[144:147], v[148:151], v[40:55]
    v_lshlrev_b32 v8, 8, v1
    v_lshl_add_u32 v8, v2, 3, v8
    v_lshl_add_u32 v8, v3, 4, v8
    s_lshl_b32 s12, s11, 13
    s_add_u32 s12, s12, 24576
    v_add_u32 v8, s12, v8
    s_lshl_b32 s13, s10, 7
    v_xor_b32 v8, s13, v8
    s_nop 2
    v_cvt_pk_bf16_f32 v56, v24, v25
    v_cvt_pk_bf16_f32 v57, v26, v27
    v_cvt_pk_bf16_f32 v58, v28, v29
    v_cvt_pk_bf16_f32 v59, v30, v31
    v_cvt_pk_bf16_f32 v60, v32, v33
    v_cvt_pk_bf16_f32 v61, v34, v35
    v_cvt_pk_bf16_f32 v62, v36, v37
    v_cvt_pk_bf16_f32 v63, v38, v39
    v_cvt_pk_bf16_f32 v64, v40, v41
    v_cvt_pk_bf16_f32 v65, v42, v43
    v_cvt_pk_bf16_f32 v66, v44, v45
    v_cvt_pk_bf16_f32 v67, v46, v47
    v_cvt_pk_bf16_f32 v68, v48, v49
    v_cvt_pk_bf16_f32 v69, v50, v51
    v_cvt_pk_bf16_f32 v70, v52, v53
    v_cvt_pk_bf16_f32 v71, v54, v55
    v_xor_b32 v72, 0x0, v8
    ds_write_b64 v72, v[56:57]
    v_xor_b32 v73, 0x10, v8
    ds_write_b64 v73, v[58:59]
    v_xor_b32 v74, 0x20, v8
    ds_write_b64 v74, v[60:61]
    v_xor_b32 v75, 0x30, v8
    ds_write_b64 v75, v[62:63]
    v_xor_b32 v76, 0x40, v8
    ds_write_b64 v76, v[64:65]
    v_xor_b32 v77, 0x50, v8
    ds_write_b64 v77, v[66:67]
    v_xor_b32 v78, 0x60, v8
    ds_write_b64 v78, v[68:69]
    v_xor_b32 v79, 0x70, v8
    ds_write_b64 v79, v[70:71]
    s_waitcnt vmcnt(0) lgkmcnt(0)
    s_barrier
    v_xor_b32 v8, v4, v3
    v_lshlrev_b32 v8, 4, v8
    v_lshl_add_u32 v152, v3, 8, v8
    v_xor_b32 v153, 0x40, v152
    v_xor_b32 v154, 0x80, v152
    v_xor_b32 v155, 0xc0, v152
    s_lshl_b32 s12, s3, 12
    s_add_u32 s12, s12, 24576
    v_add_u32 v156, s12, v152
    v_add_u32 v157, s12, v153
    v_add_u32 v158, s12, v154
    v_add_u32 v159, s12, v155
    v_add_u32 v160, 0x1e000, v152
    v_add_u32 v161, 0x1e000, v153
    v_add_u32 v162, 0x1e000, v154
    v_add_u32 v163, 0x1e000, v155
    v_lshl_add_u32 v8, v4, 2, v6
    v_lshlrev_b32 v8, 8, v8
    v_lshl_add_u32 v9, v5, 2, v6
    v_lshl_add_u32 v8, v9, 5, v8
    v_lshl_add_u32 v8, v7, 3, v8
    v_add_u32 v164, 0x22000, v8
    v_xor_b32 v165, 0x20, v164
    v_xor_b32 v166, 0x40, v164
    v_xor_b32 v167, 0x60, v164
    v_xor_b32 v168, 0x80, v164
    v_xor_b32 v169, 0xa0, v164
    v_xor_b32 v170, 0xc0, v164
    v_xor_b32 v171, 0xe0, v164
    ds_read_b128 v[172:175], v156
    ds_read_b128 v[56:59], v160 offset:0
    ds_read_b128 v[60:63], v160 offset:4096
    ds_read_b128 v[64:67], v160 offset:8192
    ds_read_b128 v[68:71], v160 offset:12288
    ds_read_b128 v[176:179], v157
    ds_read_b128 v[72:75], v161 offset:0
    ds_read_b128 v[76:79], v161 offset:4096
    ds_read_b128 v[80:83], v161 offset:8192
    ds_read_b128 v[84:87], v161 offset:12288
    ds_read_b128 v[180:183], v158
    ds_read_b128 v[88:91], v162 offset:0
    ds_read_b128 v[92:95], v162 offset:4096
    ds_read_b128 v[96:99], v162 offset:8192
    ds_read_b128 v[100:103], v162 offset:12288
    ds_read_b128 v[184:187], v159
    ds_read_b128 v[104:107], v163 offset:0
    ds_read_b128 v[108:111], v163 offset:4096
    ds_read_b128 v[112:115], v163 offset:8192
    ds_read_b128 v[116:119], v163 offset:12288
    s_waitcnt lgkmcnt(15)
    v_mfma_f32_16x16x32_bf16 v[188:191], v[56:59], v[172:175], 0
    v_mfma_f32_16x16x32_bf16 v[192:195], v[60:63], v[172:175], 0
    v_mfma_f32_16x16x32_bf16 v[196:199], v[64:67], v[172:175], 0
    v_mfma_f32_16x16x32_bf16 v[200:203], v[68:71], v[172:175], 0
    s_waitcnt lgkmcnt(13)
    v_mfma_f32_16x16x32_bf16 v[188:191], v[72:75], v[176:179], v[188:191]
    s_waitcnt lgkmcnt(12)
    v_mfma_f32_16x16x32_bf16 v[192:195], v[76:79], v[176:179], v[192:195]
    s_waitcnt lgkmcnt(11)
    v_mfma_f32_16x16x32_bf16 v[196:199], v[80:83], v[176:179], v[196:199]
    s_waitcnt lgkmcnt(10)
    v_mfma_f32_16x16x32_bf16 v[200:203], v[84:87], v[176:179], v[200:203]
    s_waitcnt lgkmcnt(8)
    v_mfma_f32_16x16x32_bf16 v[188:191], v[88:91], v[180:183], v[188:191]
    s_waitcnt lgkmcnt(7)
    v_mfma_f32_16x16x32_bf16 v[192:195], v[92:95], v[180:183], v[192:195]
    s_waitcnt lgkmcnt(6)
    v_mfma_f32_16x16x32_bf16 v[196:199], v[96:99], v[180:183], v[196:199]
    s_waitcnt lgkmcnt(5)
    v_mfma_f32_16x16x32_bf16 v[200:203], v[100:103], v[180:183], v[200:203]
    s_waitcnt lgkmcnt(3)
    v_mfma_f32_16x16x32_bf16 v[188:191], v[104:107], v[184:187], v[188:191]
    s_waitcnt lgkmcnt(2)
    v_mfma_f32_16x16x32_bf16 v[192:195], v[108:111], v[184:187], v[192:195]
    s_waitcnt lgkmcnt(1)
    v_mfma_f32_16x16x32_bf16 v[196:199], v[112:115], v[184:187], v[196:199]
    s_waitcnt lgkmcnt(0)
    v_mfma_f32_16x16x32_bf16 v[200:203], v[116:119], v[184:187], v[200:203]
    ds_read_b64_tr_b16 v[56:57], v164 offset:0
    ds_read_b64_tr_b16 v[58:59], v164 offset:4096
    ds_read_b64_tr_b16 v[60:61], v165 offset:0
    ds_read_b64_tr_b16 v[62:63], v165 offset:4096
    ds_read_b64_tr_b16 v[64:65], v166 offset:0
    ds_read_b64_tr_b16 v[66:67], v166 offset:4096
    ds_read_b64_tr_b16 v[68:69], v167 offset:0
    ds_read_b64_tr_b16 v[70:71], v167 offset:4096
    ds_read_b64_tr_b16 v[72:73], v168 offset:0
    ds_read_b64_tr_b16 v[74:75], v168 offset:4096
    ds_read_b64_tr_b16 v[76:77], v169 offset:0
    ds_read_b64_tr_b16 v[78:79], v169 offset:4096
    ds_read_b64_tr_b16 v[80:81], v170 offset:0
    ds_read_b64_tr_b16 v[82:83], v170 offset:4096
    ds_read_b64_tr_b16 v[84:85], v171 offset:0
    ds_read_b64_tr_b16 v[86:87], v171 offset:4096
    ds_read_b64_tr_b16 v[88:89], v164 offset:8192
    ds_read_b64_tr_b16 v[90:91], v164 offset:12288
    ds_read_b64_tr_b16 v[92:93], v165 offset:8192
    ds_read_b64_tr_b16 v[94:95], v165 offset:12288
    ds_read_b64_tr_b16 v[96:97], v166 offset:8192
    ds_read_b64_tr_b16 v[98:99], v166 offset:12288
    ds_read_b64_tr_b16 v[100:101], v167 offset:8192
    ds_read_b64_tr_b16 v[102:103], v167 offset:12288
    ds_read_b64_tr_b16 v[104:105], v168 offset:8192
    ds_read_b64_tr_b16 v[106:107], v168 offset:12288
    ds_read_b64_tr_b16 v[108:109], v169 offset:8192
    ds_read_b64_tr_b16 v[110:111], v169 offset:12288
    ds_read_b64_tr_b16 v[112:113], v170 offset:8192
    ds_read_b64_tr_b16 v[114:115], v170 offset:12288
    ds_read_b64_tr_b16 v[116:117], v171 offset:8192
    ds_read_b64_tr_b16 v[118:119], v171 offset:12288
    v_max3_f32 v236, v188, v189, v190
    v_max3_f32 v237, v191, v192, v193
    v_max3_f32 v238, v194, v195, v196
    v_max3_f32 v239, v197, v198, v199
    v_max3_f32 v240, v200, v201, v202
    v_max3_f32 v236, v236, v237, v203
    v_max3_f32 v238, v238, v239, v240
    v_max_f32 v236, v236, v238
    v_mov_b32 v237, v236
    s_nop 1
    v_permlane32_swap_b32 v236, v237
    v_max_f32 v236, v236, v237
    v_mov_b32 v237, v236
    s_nop 1
    v_permlane16_swap_b32 v236, v237
    v_max_f32 v236, v236, v237
    s_mov_b32 s14, 0x3e0293ee
    v_mul_f32 v237, s14, v236
    v_fma_f32 v128, v188, s14, -v237
    v_fma_f32 v129, v189, s14, -v237
    v_fma_f32 v130, v190, s14, -v237
    v_fma_f32 v131, v191, s14, -v237
    v_fma_f32 v132, v192, s14, -v237
    v_fma_f32 v133, v193, s14, -v237
    v_fma_f32 v134, v194, s14, -v237
    v_fma_f32 v135, v195, s14, -v237
    v_fma_f32 v136, v196, s14, -v237
    v_fma_f32 v137, v197, s14, -v237
    v_fma_f32 v138, v198, s14, -v237
    v_fma_f32 v139, v199, s14, -v237
    v_fma_f32 v140, v200, s14, -v237
    v_fma_f32 v141, v201, s14, -v237
    v_fma_f32 v142, v202, s14, -v237
    v_fma_f32 v143, v203, s14, -v237
    v_exp_f32 v128, v128
    v_exp_f32 v129, v129
    v_exp_f32 v130, v130
    v_exp_f32 v131, v131
    v_exp_f32 v132, v132
    v_exp_f32 v133, v133
    v_exp_f32 v134, v134
    v_exp_f32 v135, v135
    v_exp_f32 v136, v136
    v_exp_f32 v137, v137
    v_exp_f32 v138, v138
    v_exp_f32 v139, v139
    v_exp_f32 v140, v140
    v_exp_f32 v141, v141
    v_exp_f32 v142, v142
    v_exp_f32 v143, v143
    v_cvt_pk_bf16_f32 v120, v128, v129
    v_cvt_pk_bf16_f32 v121, v130, v131
    v_cvt_pk_bf16_f32 v122, v132, v133
    v_cvt_pk_bf16_f32 v123, v134, v135
    v_cvt_pk_bf16_f32 v124, v136, v137
    v_cvt_pk_bf16_f32 v125, v138, v139
    v_cvt_pk_bf16_f32 v126, v140, v141
    v_cvt_pk_bf16_f32 v127, v142, v143
    s_waitcnt lgkmcnt(0)
    v_mfma_f32_16x16x32_bf16 v[204:207], v[56:59], v[120:123], 0
    v_mfma_f32_16x16x32_bf16 v[208:211], v[60:63], v[120:123], 0
    v_mfma_f32_16x16x32_bf16 v[212:215], v[64:67], v[120:123], 0
    v_mfma_f32_16x16x32_bf16 v[216:219], v[68:71], v[120:123], 0
    v_mfma_f32_16x16x32_bf16 v[220:223], v[72:75], v[120:123], 0
    v_mfma_f32_16x16x32_bf16 v[224:227], v[76:79], v[120:123], 0
    v_mfma_f32_16x16x32_bf16 v[228:231], v[80:83], v[120:123], 0
    v_mfma_f32_16x16x32_bf16 v[232:235], v[84:87], v[120:123], 0
    v_mfma_f32_16x16x32_bf16 v[204:207], v[88:91], v[124:127], v[204:207]
    v_mfma_f32_16x16x32_bf16 v[208:211], v[92:95], v[124:127], v[208:211]
    v_mfma_f32_16x16x32_bf16 v[212:215], v[96:99], v[124:127], v[212:215]
    v_mfma_f32_16x16x32_bf16 v[216:219], v[100:103], v[124:127], v[216:219]
    v_mfma_f32_16x16x32_bf16 v[220:223], v[104:107], v[124:127], v[220:223]
    v_mfma_f32_16x16x32_bf16 v[224:227], v[108:111], v[124:127], v[224:227]
    v_mfma_f32_16x16x32_bf16 v[228:231], v[112:115], v[124:127], v[228:231]
    v_mfma_f32_16x16x32_bf16 v[232:235], v[116:119], v[124:127], v[232:235]
    v_add_f32 v238, v128, v129
    v_add_f32 v238, v238, v130
    v_add_f32 v238, v238, v131
    v_add_f32 v238, v238, v132
    v_add_f32 v238, v238, v133
    v_add_f32 v238, v238, v134
    v_add_f32 v238, v238, v135
    v_add_f32 v238, v238, v136
    v_add_f32 v238, v238, v137
    v_add_f32 v238, v238, v138
    v_add_f32 v238, v238, v139
    v_add_f32 v238, v238, v140
    v_add_f32 v238, v238, v141
    v_add_f32 v238, v238, v142
    v_add_f32 v238, v238, v143
    v_mov_b32 v239, v238
    s_nop 1
    v_permlane32_swap_b32 v238, v239
    v_add_f32 v238, v238, v239
    v_mov_b32 v239, v238
    s_nop 1
    v_permlane16_swap_b32 v238, v239
    v_add_f32 v238, v238, v239
    v_rcp_f32 v240, v238
    v_lshlrev_b32 v8, 13, v3
    v_lshl_add_u32 v8, v4, 3, v8
    s_lshl_b32 s12, s6, 19
    s_lshl_b32 s13, s3, 17
    s_add_u32 s12, s12, s13
    s_lshl_b32 s13, s7, 8
    s_add_u32 s12, s12, s13
    v_mul_f32 v204, v204, v240
    v_mul_f32 v205, v205, v240
    v_mul_f32 v206, v206, v240
    v_mul_f32 v207, v207, v240
    v_cvt_pk_bf16_f32 v24, v204, v205
    v_cvt_pk_bf16_f32 v25, v206, v207
    buffer_store_dwordx2 v[24:25], v8, s[48:51], s12 offen offset:0
    v_mul_f32 v208, v208, v240
    v_mul_f32 v209, v209, v240
    v_mul_f32 v210, v210, v240
    v_mul_f32 v211, v211, v240
    v_cvt_pk_bf16_f32 v26, v208, v209
    v_cvt_pk_bf16_f32 v27, v210, v211
    buffer_store_dwordx2 v[26:27], v8, s[48:51], s12 offen offset:32
    v_mul_f32 v212, v212, v240
    v_mul_f32 v213, v213, v240
    v_mul_f32 v214, v214, v240
    v_mul_f32 v215, v215, v240
    v_cvt_pk_bf16_f32 v28, v212, v213
    v_cvt_pk_bf16_f32 v29, v214, v215
    buffer_store_dwordx2 v[28:29], v8, s[48:51], s12 offen offset:64
    v_mul_f32 v216, v216, v240
    v_mul_f32 v217, v217, v240
    v_mul_f32 v218, v218, v240
    v_mul_f32 v219, v219, v240
    v_cvt_pk_bf16_f32 v30, v216, v217
    v_cvt_pk_bf16_f32 v31, v218, v219
    buffer_store_dwordx2 v[30:31], v8, s[48:51], s12 offen offset:96
    v_mul_f32 v220, v220, v240
    v_mul_f32 v221, v221, v240
    v_mul_f32 v222, v222, v240
    v_mul_f32 v223, v223, v240
    v_cvt_pk_bf16_f32 v32, v220, v221
    v_cvt_pk_bf16_f32 v33, v222, v223
    buffer_store_dwordx2 v[32:33], v8, s[48:51], s12 offen offset:128
    v_mul_f32 v224, v224, v240
    v_mul_f32 v225, v225, v240
    v_mul_f32 v226, v226, v240
    v_mul_f32 v227, v227, v240
    v_cvt_pk_bf16_f32 v34, v224, v225
    v_cvt_pk_bf16_f32 v35, v226, v227
    buffer_store_dwordx2 v[34:35], v8, s[48:51], s12 offen offset:160
    v_mul_f32 v228, v228, v240
    v_mul_f32 v229, v229, v240
    v_mul_f32 v230, v230, v240
    v_mul_f32 v231, v231, v240
    v_cvt_pk_bf16_f32 v36, v228, v229
    v_cvt_pk_bf16_f32 v37, v230, v231
    buffer_store_dwordx2 v[36:37], v8, s[48:51], s12 offen offset:192
    v_mul_f32 v232, v232, v240
    v_mul_f32 v233, v233, v240
    v_mul_f32 v234, v234, v240
    v_mul_f32 v235, v235, v240
    v_cvt_pk_bf16_f32 v38, v232, v233
    v_cvt_pk_bf16_f32 v39, v234, v235
    buffer_store_dwordx2 v[38:39], v8, s[48:51], s12 offen offset:224
    s_endpgm
mha_k1_kernel_prod:
    s_sub_u32 s63, s3, 4
    v_lshrrev_b32 v1, 3, v0
    v_lshrrev_b32 v2, 4, v0
    v_and_b32 v3, 7, v0
    v_and_b32 v4, 15, v0
    s_lshl_b32 s10, s63, 4
    v_xor_b32 v5, v3, v2
    v_lshlrev_b32 v5, 4, v5
    v_add_u32 v6, s10, v1
    v_lshlrev_b32 v6, 11, v6
    v_add_u32 v10, v6, v5
    v_xor_b32 v7, 64, v5
    v_add_u32 v11, v6, v7
    v_add_u32 v11, 0x3c00, v11
    v_lshlrev_b32 v8, 2, v2
    v_xor_b32 v8, v4, v8
    v_lshlrev_b32 v8, 4, v8
    v_add_u32 v9, s10, v2
    v_lshlrev_b32 v9, 13, v9
    v_add_u32 v12, v9, v8
    v_add_u32 v13, 0x7c00, v12
    v_add_u32 v14, 0xf800, v12
    v_add_u32 v15, 0x17400, v12
    s_lshl_b32 s61, s63, 11
    s_lshl_b32 s62, s63, 12
    s_add_u32 s62, s62, 8192
    s_mov_b32 s52, s9
    s_mov_b32 s55, 0
    s_lshl_b32 s53, s52, 7
    s_add_u32 s53, s53, s56
    s_lshl_b32 s54, s52, 19
    s_add_u32 s54, s54, s57
    s_add_u32 m0, s55, s61
    s_add_u32 s52, s52, 1
    buffer_load_dwordx4 v10, s[32:35], s53 offen offset:0 lds
    buffer_load_dwordx4 v11, s[32:35], s53 offen offset:1024 lds
    s_add_u32 m0, s55, s62
    s_and_b32 s52, s52, 15
    buffer_load_dwordx4 v12, s[36:39], s54 offen offset:0 lds
    buffer_load_dwordx4 v13, s[36:39], s54 offen offset:1024 lds
    buffer_load_dwordx4 v14, s[36:39], s54 offen offset:2048 lds
    buffer_load_dwordx4 v15, s[36:39], s54 offen offset:3072 lds
    s_add_u32 s55, s55, 24576
    s_cmp_ge_u32 s55, 122880
    s_cselect_b32 s55, 0, s55
    s_lshl_b32 s53, s52, 7
    s_add_u32 s53, s53, s56
    s_lshl_b32 s54, s52, 19
    s_add_u32 s54, s54, s57
    s_add_u32 m0, s55, s61
    s_add_u32 s52, s52, 1
    buffer_load_dwordx4 v10, s[32:35], s53 offen offset:0 lds
    buffer_load_dwordx4 v11, s[32:35], s53 offen offset:1024 lds
    s_add_u32 m0, s55, s62
    s_and_b32 s52, s52, 15
    buffer_load_dwordx4 v12, s[36:39], s54 offen offset:0 lds
    buffer_load_dwordx4 v13, s[36:39], s54 offen offset:1024 lds
    buffer_load_dwordx4 v14, s[36:39], s54 offen offset:2048 lds
    buffer_load_dwordx4 v15, s[36:39], s54 offen offset:3072 lds
    s_add_u32 s55, s55, 24576
    s_cmp_ge_u32 s55, 122880
    s_cselect_b32 s55, 0, s55
    s_lshl_b32 s53, s52, 7
    s_add_u32 s53, s53, s56
    s_lshl_b32 s54, s52, 19
    s_add_u32 s54, s54, s57
    s_add_u32 m0, s55, s61
    s_add_u32 s52, s52, 1
    buffer_load_dwordx4 v10, s[32:35], s53 offen offset:0 lds
    buffer_load_dwordx4 v11, s[32:35], s53 offen offset:1024 lds
    s_add_u32 m0, s55, s62
    s_and_b32 s52, s52, 15
    buffer_load_dwordx4 v12, s[36:39], s54 offen offset:0 lds
    buffer_load_dwordx4 v13, s[36:39], s54 offen offset:1024 lds
    buffer_load_dwordx4 v14, s[36:39], s54 offen offset:2048 lds
    buffer_load_dwordx4 v15, s[36:39], s54 offen offset:3072 lds
    s_add_u32 s55, s55, 24576
    s_cmp_ge_u32 s55, 122880
    s_cselect_b32 s55, 0, s55
    s_lshl_b32 s53, s52, 7
    s_add_u32 s53, s53, s56
    s_lshl_b32 s54, s52, 19
    s_add_u32 s54, s54, s57
    s_add_u32 m0, s55, s61
    s_add_u32 s52, s52, 1
    buffer_load_dwordx4 v10, s[32:35], s53 offen offset:0 lds
    buffer_load_dwordx4 v11, s[32:35], s53 offen offset:1024 lds
    s_add_u32 m0, s55, s62
    s_and_b32 s52, s52, 15
    buffer_load_dwordx4 v12, s[36:39], s54 offen offset:0 lds
    buffer_load_dwordx4 v13, s[36:39], s54 offen offset:1024 lds
    buffer_load_dwordx4 v14, s[36:39], s54 offen offset:2048 lds
    buffer_load_dwordx4 v15, s[36:39], s54 offen offset:3072 lds
    s_add_u32 s55, s55, 24576
    s_cmp_ge_u32 s55, 122880
    s_cselect_b32 s55, 0, s55
    s_mov_b32 s58, 0
mha_k1_kernel_ploop:
    s_waitcnt vmcnt(18)
    s_barrier
    s_lshl_b32 s53, s52, 7
    s_add_u32 s53, s53, s56
    s_lshl_b32 s54, s52, 19
    s_add_u32 s54, s54, s57
    s_add_u32 m0, s55, s61
    s_add_u32 s52, s52, 1
    buffer_load_dwordx4 v10, s[32:35], s53 offen offset:0 lds
    buffer_load_dwordx4 v11, s[32:35], s53 offen offset:1024 lds
    s_add_u32 m0, s55, s62
    s_and_b32 s52, s52, 15
    buffer_load_dwordx4 v12, s[36:39], s54 offen offset:0 lds
    buffer_load_dwordx4 v13, s[36:39], s54 offen offset:1024 lds
    buffer_load_dwordx4 v14, s[36:39], s54 offen offset:2048 lds
    buffer_load_dwordx4 v15, s[36:39], s54 offen offset:3072 lds
    s_add_u32 s55, s55, 24576
    s_cmp_ge_u32 s55, 122880
    s_cselect_b32 s55, 0, s55
    s_add_u32 s58, s58, 1
    s_cmp_lt_u32 s58, 12
    s_cbranch_scc1 mha_k1_kernel_ploop
    s_lshl_b32 s64, s6, 5
    s_add_u32 s64, s64, s7
    s_lshl_b32 s64, s64, 14
    s_lshl_b32 s65, s63, 12
    v_xor_b32 v16, v4, v2
    v_lshlrev_b32 v16, 4, v16
    v_lshl_add_u32 v16, v2, 8, v16
    v_add_u32 v16, s65, v16
    s_add_u32 s66, s65, 122880
    s_mov_b32 m0, s66
    s_nop 0
    buffer_load_dwordx4 v16, s[40:43], s64 offen offset:0 lds
    v_xor_b32 v17, 0x40, v16
    buffer_load_dwordx4 v17, s[40:43], s64 offen offset:1024 lds
    v_xor_b32 v17, 0x80, v16
    buffer_load_dwordx4 v17, s[40:43], s64 offen offset:2048 lds
    v_xor_b32 v17, 0xc0, v16
    buffer_load_dwordx4 v17, s[40:43], s64 offen offset:3072 lds
    v_lshlrev_b32 v18, 1, v2
    v_xor_b32 v18, v4, v18
    v_lshlrev_b32 v18, 4, v18
    v_lshl_add_u32 v18, v2, 8, v18
    v_add_u32 v18, s65, v18
    v_xor_b32 v19, 0x80, v18
    s_add_u32 s66, s65, 139264
    s_mov_b32 m0, s66
    s_nop 0
    buffer_load_dwordx4 v18, s[44:47], s64 offen offset:0 lds
    buffer_load_dwordx4 v19, s[44:47], s64 offen offset:1024 lds
    buffer_load_dwordx4 v18, s[44:47], s64 offen offset:2048 lds
    buffer_load_dwordx4 v19, s[44:47], s64 offen offset:3072 lds
    s_waitcnt vmcnt(26)
    s_barrier
    s_waitcnt vmcnt(20)
    s_barrier
    s_waitcnt vmcnt(14)
    s_barrier
    s_waitcnt vmcnt(8)
    s_barrier
    s_waitcnt vmcnt(0)
    v_lshrrev_b32 v20, 1, v0
    v_lshlrev_b32 v20, 14, v20
    v_and_b32 v21, 1, v0
    v_lshl_add_u32 v20, v21, 7, v20
    s_lshr_b32 s64, s4, 1
    s_lshl_b32 s64, s64, 21
    s_and_b32 s65, s4, 1
    s_lshl_b32 s65, s65, 2
    s_add_u32 s65, s65, s5
    s_lshl_b32 s65, s65, 8
    s_add_u32 s64, s64, s65
    s_lshl_b32 s65, s6, 11
    s_add_u32 s64, s64, s65
    s_lshl_b32 s65, s63, 19
    s_add_u32 s64, s64, s65
    buffer_load_dword v22, v20, s[92:95], s64 offen
mha_k1_kernel_end:
    s_endpgm
.globl mha_k2_kernel
.p2align 8
.type mha_k2_kernel,@function
mha_k2_kernel:
    s_cmp_ge_u32 s2, 256
    s_cbranch_scc1 mha_k2_kernel_end
    s_load_dwordx16 s[16:31], s[0:1], 0
    v_lshrrev_b32 v1, 6, v0
    v_and_b32 v0, 63, v0
    s_and_b32 s4, s2, 7
    v_readfirstlane_b32 s3, v1
    s_lshr_b32 s5, s2, 3
    s_and_b32 s5, s5, 3
    s_lshr_b32 s6, s2, 5
    s_lshr_b32 s8, s4, 1
    s_and_b32 s7, s4, 1
    s_lshl_b32 s7, s7, 2
    s_add_u32 s7, s7, s5
    s_lshl_b32 s56, s6, 19
    s_lshl_b32 s10, s8, 11
    s_add_u32 s56, s56, s10
    s_lshl_b32 s57, s8, 21
    s_lshl_b32 s10, s7, 8
    s_add_u32 s57, s57, s10
    s_lshl_b32 s9, s6, 1
    s_lshl_b32 s10, s5, 2
    s_add_u32 s9, s9, s10
    s_and_b32 s9, s9, 15
    s_waitcnt lgkmcnt(0)
    s_mov_b32 s32, s30
    s_mov_b32 s33, s31
    s_mov_b32 s34, 0x400000
    s_mov_b32 s35, 0x00020000
    s_mov_b32 s36, s24
    s_mov_b32 s37, s25
    s_mov_b32 s38, 0x800000
    s_mov_b32 s39, 0x00020000
    s_mov_b32 s48, s30
    s_mov_b32 s49, s31
    s_mov_b32 s50, 0x2000000
    s_mov_b32 s51, 0x00020000
    s_mov_b32 s92, s26
    s_mov_b32 s93, s27
    s_mov_b32 s94, 0x100000
    s_mov_b32 s95, 0x00020000
    s_cmp_ge_u32 s3, 4
    s_cbranch_scc1 mha_k2_kernel_prod
    v_and_b32 v1, 31, v0
    v_lshrrev_b32 v2, 5, v0
    v_and_b32 v3, 15, v0
    v_lshrrev_b32 v4, 4, v0
    v_and_b32 v5, 1, v4
    v_lshrrev_b32 v6, 2, v3
    v_and_b32 v7, 3, v3
    s_and_b32 s10, s3, 1
    s_lshr_b32 s11, s3, 1
    v_bfe_u32 v8, v1, 1, 3
    v_xor_b32 v8, v2, v8
    v_lshlrev_b32 v8, 4, v8
    v_lshlrev_b32 v9, 7, v1
    s_lshl_b32 s12, s11, 12
    s_add_u32 s12, s12, 0
    v_add_u32 v9, s12, v9
    v_add_u32 v16, v9, v8
    v_xor_b32 v17, 32, v16
    v_xor_b32 v18, 64, v16
    v_xor_b32 v19, 0x60, v16
    s_lshl_b32 s13, s10, 1
    v_xor_b32 v10, s13, v6
    v_lshlrev_b32 v10, 6, v10
    v_lshlrev_b32 v11, 11, v2
    v_lshl_add_u32 v11, v6, 8, v11
    v_add_u32 v10, v10, v11
    v_lshl_add_u32 v10, v5, 5, v10
    v_lshl_add_u32 v10, v7, 3, v10
    v_add_u32 v20, 8192, v10
    v_xor_b32 v21, 64, v20
    v_mov_b32 v24, 0
    v_mov_b32 v25, 0
    v_mov_b32 v26, 0
    v_mov_b32 v27, 0
    v_mov_b32 v28, 0
    v_mov_b32 v29, 0
    v_mov_b32 v30, 0
    v_mov_b32 v31, 0
    v_mov_b32 v32, 0
    v_mov_b32 v33, 0
    v_mov_b32 v34, 0
    v_mov_b32 v35, 0
    v_mov_b32 v36, 0
    v_mov_b32 v37, 0
    v_mov_b32 v38, 0
    v_mov_b32 v39, 0
    v_mov_b32 v40, 0
    v_mov_b32 v41, 0
    v_mov_b32 v42, 0
    v_mov_b32 v43, 0
    v_mov_b32 v44, 0
    v_mov_b32 v45, 0
    v_mov_b32 v46, 0
    v_mov_b32 v47, 0
    v_mov_b32 v48, 0
    v_mov_b32 v49, 0
    v_mov_b32 v50, 0
    v_mov_b32 v51, 0
    v_mov_b32 v52, 0
    v_mov_b32 v53, 0
    v_mov_b32 v54, 0
    v_mov_b32 v55, 0
    v_mov_b32 v104, 0
    v_mov_b32 v105, 0
    v_mov_b32 v106, 0
    v_mov_b32 v107, 0
    v_mov_b32 v108, 0
    v_mov_b32 v109, 0
    v_mov_b32 v110, 0
    v_mov_b32 v111, 0
    v_mov_b32 v112, 0
    v_mov_b32 v113, 0
    v_mov_b32 v114, 0
    v_mov_b32 v115, 0
    v_mov_b32 v116, 0
    v_mov_b32 v117, 0
    v_mov_b32 v118, 0
    v_mov_b32 v119, 0
    v_mov_b32 v120, 0
    v_mov_b32 v121, 0
    v_mov_b32 v122, 0
    v_mov_b32 v123, 0
    v_mov_b32 v124, 0
    v_mov_b32 v125, 0
    v_mov_b32 v126, 0
    v_mov_b32 v127, 0
    v_mov_b32 v128, 0
    v_mov_b32 v129, 0
    v_mov_b32 v130, 0
    v_mov_b32 v131, 0
    v_mov_b32 v132, 0
    v_mov_b32 v133, 0
    v_mov_b32 v134, 0
    v_mov_b32 v135, 0
    v_mov_b32 v136, 0
    v_mov_b32 v137, 0
    v_mov_b32 v138, 0
    v_mov_b32 v139, 0
    v_mov_b32 v140, 0
    v_mov_b32 v141, 0
    v_mov_b32 v142, 0
    v_mov_b32 v143, 0
    v_mov_b32 v144, 0
    v_mov_b32 v145, 0
    v_mov_b32 v146, 0
    v_mov_b32 v147, 0
    v_mov_b32 v148, 0
    v_mov_b32 v149, 0
    v_mov_b32 v150, 0
    v_mov_b32 v151, 0
    s_mov_b32 s60, 0
    s_mov_b32 s61, 0
    s_mov_b32 s62, 24576
    s_mov_b32 s63, 4294844416
mha_k2_kernel_cons:
    s_barrier
    ds_read_b128 v[64:67], v16
    ds_read_b64_tr_b16 v[56:57], v20 offset:0
    ds_read_b64_tr_b16 v[58:59], v20 offset:1024
    ds_read_b64_tr_b16 v[60:61], v21 offset:0
    ds_read_b64_tr_b16 v[62:63], v21 offset:1024
    v_mfma_f32_32x32x16_bf16 v[24:39], v[104:107], v[112:115], v[24:39]
    v_mfma_f32_32x32x16_bf16 v[40:55], v[108:111], v[112:115], v[40:55]
    ds_read_b128 v[76:79], v17
    ds_read_b64_tr_b16 v[68:69], v20 offset:4096
    ds_read_b64_tr_b16 v[70:71], v20 offset:5120
    ds_read_b64_tr_b16 v[72:73], v21 offset:4096
    ds_read_b64_tr_b16 v[74:75], v21 offset:5120
    v_mfma_f32_32x32x16_bf16 v[24:39], v[116:119], v[124:127], v[24:39]
    v_mfma_f32_32x32x16_bf16 v[40:55], v[120:123], v[124:127], v[40:55]
    ds_read_b128 v[88:91], v18
    ds_read_b64_tr_b16 v[80:81], v20 offset:8192
    ds_read_b64_tr_b16 v[82:83], v20 offset:9216
    ds_read_b64_tr_b16 v[84:85], v21 offset:8192
    ds_read_b64_tr_b16 v[86:87], v21 offset:9216
    v_mfma_f32_32x32x16_bf16 v[24:39], v[128:131], v[136:139], v[24:39]
    v_mfma_f32_32x32x16_bf16 v[40:55], v[132:135], v[136:139], v[40:55]
    ds_read_b128 v[100:103], v19
    ds_read_b64_tr_b16 v[92:93], v20 offset:12288
    ds_read_b64_tr_b16 v[94:95], v20 offset:13312
    ds_read_b64_tr_b16 v[96:97], v21 offset:12288
    ds_read_b64_tr_b16 v[98:99], v21 offset:13312
    v_mfma_f32_32x32x16_bf16 v[24:39], v[140:143], v[148:151], v[24:39]
    v_mfma_f32_32x32x16_bf16 v[40:55], v[144:147], v[148:151], v[40:55]
    s_add_u32 s60, s60, 1
    s_cmp_eq_u32 s60, 6
    s_cselect_b32 s59, s63, s62
    s_cselect_b32 s60, 0, s60
    v_add_u32 v16, s59, v16
    v_add_u32 v17, s59, v17
    v_add_u32 v18, s59, v18
    v_add_u32 v19, s59, v19
    v_add_u32 v20, s59, v20
    v_add_u32 v21, s59, v21
    s_waitcnt lgkmcnt(0)
    s_barrier
    ds_read_b128 v[112:115], v16
    ds_read_b64_tr_b16 v[104:105], v20 offset:0
    ds_read_b64_tr_b16 v[106:107], v20 offset:1024
    ds_read_b64_tr_b16 v[108:109], v21 offset:0
    ds_read_b64_tr_b16 v[110:111], v21 offset:1024
    v_mfma_f32_32x32x16_bf16 v[24:39], v[56:59], v[64:67], v[24:39]
    v_mfma_f32_32x32x16_bf16 v[40:55], v[60:63], v[64:67], v[40:55]
    ds_read_b128 v[124:127], v17
    ds_read_b64_tr_b16 v[116:117], v20 offset:4096
    ds_read_b64_tr_b16 v[118:119], v20 offset:5120
    ds_read_b64_tr_b16 v[120:121], v21 offset:4096
    ds_read_b64_tr_b16 v[122:123], v21 offset:5120
    v_mfma_f32_32x32x16_bf16 v[24:39], v[68:71], v[76:79], v[24:39]
    v_mfma_f32_32x32x16_bf16 v[40:55], v[72:75], v[76:79], v[40:55]
    ds_read_b128 v[136:139], v18
    ds_read_b64_tr_b16 v[128:129], v20 offset:8192
    ds_read_b64_tr_b16 v[130:131], v20 offset:9216
    ds_read_b64_tr_b16 v[132:133], v21 offset:8192
    ds_read_b64_tr_b16 v[134:135], v21 offset:9216
    v_mfma_f32_32x32x16_bf16 v[24:39], v[80:83], v[88:91], v[24:39]
    v_mfma_f32_32x32x16_bf16 v[40:55], v[84:87], v[88:91], v[40:55]
    ds_read_b128 v[148:151], v19
    ds_read_b64_tr_b16 v[140:141], v20 offset:12288
    ds_read_b64_tr_b16 v[142:143], v20 offset:13312
    ds_read_b64_tr_b16 v[144:145], v21 offset:12288
    ds_read_b64_tr_b16 v[146:147], v21 offset:13312
    v_mfma_f32_32x32x16_bf16 v[24:39], v[92:95], v[100:103], v[24:39]
    v_mfma_f32_32x32x16_bf16 v[40:55], v[96:99], v[100:103], v[40:55]
    s_add_u32 s60, s60, 1
    s_cmp_eq_u32 s60, 6
    s_cselect_b32 s59, s63, s62
    s_cselect_b32 s60, 0, s60
    v_add_u32 v16, s59, v16
    v_add_u32 v17, s59, v17
    v_add_u32 v18, s59, v18
    v_add_u32 v19, s59, v19
    v_add_u32 v20, s59, v20
    v_add_u32 v21, s59, v21
    s_waitcnt lgkmcnt(0)
    s_add_u32 s61, s61, 2
    s_cmp_lt_u32 s61, 16
    s_cbranch_scc1 mha_k2_kernel_cons
    v_mfma_f32_32x32x16_bf16 v[24:39], v[104:107], v[112:115], v[24:39]
    v_mfma_f32_32x32x16_bf16 v[40:55], v[108:111], v[112:115], v[40:55]
    v_mfma_f32_32x32x16_bf16 v[24:39], v[116:119], v[124:127], v[24:39]
    v_mfma_f32_32x32x16_bf16 v[40:55], v[120:123], v[124:127], v[40:55]
    v_mfma_f32_32x32x16_bf16 v[24:39], v[128:131], v[136:139], v[24:39]
    v_mfma_f32_32x32x16_bf16 v[40:55], v[132:135], v[136:139], v[40:55]
    v_mfma_f32_32x32x16_bf16 v[24:39], v[140:143], v[148:151], v[24:39]
    v_mfma_f32_32x32x16_bf16 v[40:55], v[144:147], v[148:151], v[40:55]
    s_lshl_b32 s12, s6, 3
    s_add_u32 s12, s12, s7
    s_lshl_b32 s14, s12, 2
    s_add_u32 s14, s14, s3
    s_lshl_b32 s14, s14, 13
    s_add_u32 s14, s14, 0x400000
    s_lshl_b32 s13, s8, 21
    s_add_u32 s15, s14, s13
    s_add_u32 s13, s15, 4096
    v_lshlrev_b32 v8, 4, v0
    s_nop 0
    buffer_store_dwordx4 v[24:27], v8, s[48:51], s15 offen offset:0 sc1
    buffer_store_dwordx4 v[28:31], v8, s[48:51], s15 offen offset:1024 sc1
    buffer_store_dwordx4 v[32:35], v8, s[48:51], s15 offen offset:2048 sc1
    buffer_store_dwordx4 v[36:39], v8, s[48:51], s15 offen offset:3072 sc1
    buffer_store_dwordx4 v[40:43], v8, s[48:51], s13 offen offset:0 sc1
    buffer_store_dwordx4 v[44:47], v8, s[48:51], s13 offen offset:1024 sc1
    buffer_store_dwordx4 v[48:51], v8, s[48:51], s13 offen offset:2048 sc1
    buffer_store_dwordx4 v[52:55], v8, s[48:51], s13 offen offset:3072 sc1
    s_waitcnt vmcnt(0)
    s_barrier
    s_cmp_lg_u32 s3, 0
    s_cbranch_scc1 mha_k2_kernel_noat
    s_lshl_b32 s13, s12, 8
    s_add_u32 s13, s13, 0x1000000
    v_mov_b32 v9, 1
    v_mov_b32 v10, 0
    s_mov_b64 exec, 1
    buffer_atomic_add v9, v10, s[48:51], s13 offen sc0 sc1
    s_waitcnt vmcnt(0)
    v_readfirstlane_b32 s52, v9
    s_nop 0
    s_add_u32 s52, s52, 1
    s_mov_b32 s53, 0
mha_k2_kernel_spin:
    s_cmp_ge_u32 s52, 4
    s_cbranch_scc1 mha_k2_kernel_spun
    s_sleep 1
    buffer_load_dword v9, v10, s[48:51], s13 offen sc1
    s_waitcnt vmcnt(0)
    v_readfirstlane_b32 s52, v9
    s_add_u32 s53, s53, 1
    s_cmp_lt_u32 s53, 0x20000
    s_cbranch_scc1 mha_k2_kernel_spin
mha_k2_kernel_spun:
    s_mov_b64 exec, -1
mha_k2_kernel_noat:
    s_barrier
    s_lshl_b32 s14, s12, 2
    s_add_u32 s14, s14, s8
    s_lshl_b32 s14, s14, 13
    s_add_u32 s14, s14, 0x400000
    s_lshl_b32 s13, s3, 11
    s_add_u32 s14, s14, s13
    s_add_u32 s53, s14, 0x200000
    s_add_u32 s54, s14, 0x400000
    s_add_u32 s55, s14, 0x600000
    buffer_load_dwordx4 v[56:59], v8, s[48:51], s14 offen offset:0 sc1
    buffer_load_dwordx4 v[60:63], v8, s[48:51], s53 offen offset:0 sc1
    buffer_load_dwordx4 v[64:67], v8, s[48:51], s54 offen offset:0 sc1
    buffer_load_dwordx4 v[68:71], v8, s[48:51], s55 offen offset:0 sc1
    buffer_load_dwordx4 v[72:75], v8, s[48:51], s14 offen offset:1024 sc1
    buffer_load_dwordx4 v[76:79], v8, s[48:51], s53 offen offset:1024 sc1
    buffer_load_dwordx4 v[80:83], v8, s[48:51], s54 offen offset:1024 sc1
    buffer_load_dwordx4 v[84:87], v8, s[48:51], s55 offen offset:1024 sc1
    v_lshlrev_b32 v9, 11, v1
    v_lshl_add_u32 v9, v2, 3, v9
    s_lshl_b32 s12, s6, 17
    s_lshr_b32 s13, s8, 1
    s_lshl_b32 s13, s13, 16
    s_add_u32 s12, s12, s13
    s_lshl_b32 s13, s7, 8
    s_add_u32 s12, s12, s13
    s_and_b32 s13, s8, 1
    s_lshl_b32 s13, s13, 7
    s_add_u32 s12, s12, s13
    s_lshr_b32 s13, s3, 1
    s_lshl_b32 s13, s13, 6
    s_add_u32 s12, s12, s13
    s_and_b32 s13, s3, 1
    s_lshl_b32 s13, s13, 5
    s_add_u32 s12, s12, s13
    s_waitcnt vmcnt(4)
    v_add_f32 v56, v56, v60
    v_add_f32 v56, v56, v64
    v_add_f32 v56, v56, v68
    v_add_f32 v57, v57, v61
    v_add_f32 v57, v57, v65
    v_add_f32 v57, v57, v69
    v_add_f32 v58, v58, v62
    v_add_f32 v58, v58, v66
    v_add_f32 v58, v58, v70
    v_add_f32 v59, v59, v63
    v_add_f32 v59, v59, v67
    v_add_f32 v59, v59, v71
    v_cvt_pk_bf16_f32 v60, v56, v57
    v_cvt_pk_bf16_f32 v61, v58, v59
    buffer_store_dwordx2 v[60:61], v9, s[92:95], s12 offen offset:0
    s_waitcnt vmcnt(0)
    v_add_f32 v72, v72, v76
    v_add_f32 v72, v72, v80
    v_add_f32 v72, v72, v84
    v_add_f32 v73, v73, v77
    v_add_f32 v73, v73, v81
    v_add_f32 v73, v73, v85
    v_add_f32 v74, v74, v78
    v_add_f32 v74, v74, v82
    v_add_f32 v74, v74, v86
    v_add_f32 v75, v75, v79
    v_add_f32 v75, v75, v83
    v_add_f32 v75, v75, v87
    v_cvt_pk_bf16_f32 v76, v72, v73
    v_cvt_pk_bf16_f32 v77, v74, v75
    buffer_store_dwordx2 v[76:77], v9, s[92:95], s12 offen offset:16
    s_endpgm
mha_k2_kernel_prod:
    s_sub_u32 s63, s3, 4
    v_lshrrev_b32 v1, 3, v0
    v_lshrrev_b32 v2, 4, v0
    v_and_b32 v3, 7, v0
    v_and_b32 v4, 15, v0
    s_lshl_b32 s10, s63, 4
    v_xor_b32 v5, v3, v2
    v_lshlrev_b32 v5, 4, v5
    v_add_u32 v6, s10, v1
    v_lshlrev_b32 v6, 13, v6
    v_add_u32 v10, v6, v5
    v_xor_b32 v7, 64, v5
    v_add_u32 v11, v6, v7
    v_add_u32 v11, 0xfc00, v11
    v_lshlrev_b32 v8, 2, v2
    v_xor_b32 v8, v4, v8
    v_lshlrev_b32 v8, 4, v8
    v_add_u32 v9, s10, v2
    v_lshlrev_b32 v9, 11, v9
    v_add_u32 v12, v9, v8
    v_add_u32 v13, 0x1c00, v12
    v_add_u32 v14, 0x3800, v12
    v_add_u32 v15, 0x5400, v12
    s_lshl_b32 s61, s63, 11
    s_lshl_b32 s62, s63, 12
    s_add_u32 s62, s62, 8192
    s_mov_b32 s52, s9
    s_mov_b32 s55, 0
    s_lshl_b32 s53, s52, 7
    s_add_u32 s53, s53, s56
    s_lshl_b32 s54, s52, 17
    s_add_u32 s54, s54, s57
    s_add_u32 m0, s55, s61
    s_add_u32 s52, s52, 1
    buffer_load_dwordx4 v10, s[32:35], s53 offen offset:0 lds
    buffer_load_dwordx4 v11, s[32:35], s53 offen offset:1024 lds
    s_add_u32 m0, s55, s62
    s_and_b32 s52, s52, 15
    buffer_load_dwordx4 v12, s[36:39], s54 offen offset:0 lds
    buffer_load_dwordx4 v13, s[36:39], s54 offen offset:1024 lds
    buffer_load_dwordx4 v14, s[36:39], s54 offen offset:2048 lds
    buffer_load_dwordx4 v15, s[36:39], s54 offen offset:3072 lds
    s_add_u32 s55, s55, 24576
    s_cmp_ge_u32 s55, 147456
    s_cselect_b32 s55, 0, s55
    s_lshl_b32 s53, s52, 7
    s_add_u32 s53, s53, s56
    s_lshl_b32 s54, s52, 17
    s_add_u32 s54, s54, s57
    s_add_u32 m0, s55, s61
    s_add_u32 s52, s52, 1
    buffer_load_dwordx4 v10, s[32:35], s53 offen offset:0 lds
    buffer_load_dwordx4 v11, s[32:35], s53 offen offset:1024 lds
    s_add_u32 m0, s55, s62
    s_and_b32 s52, s52, 15
    buffer_load_dwordx4 v12, s[36:39], s54 offen offset:0 lds
    buffer_load_dwordx4 v13, s[36:39], s54 offen offset:1024 lds
    buffer_load_dwordx4 v14, s[36:39], s54 offen offset:2048 lds
    buffer_load_dwordx4 v15, s[36:39], s54 offen offset:3072 lds
    s_add_u32 s55, s55, 24576
    s_cmp_ge_u32 s55, 147456
    s_cselect_b32 s55, 0, s55
    s_lshl_b32 s53, s52, 7
    s_add_u32 s53, s53, s56
    s_lshl_b32 s54, s52, 17
    s_add_u32 s54, s54, s57
    s_add_u32 m0, s55, s61
    s_add_u32 s52, s52, 1
    buffer_load_dwordx4 v10, s[32:35], s53 offen offset:0 lds
    buffer_load_dwordx4 v11, s[32:35], s53 offen offset:1024 lds
    s_add_u32 m0, s55, s62
    s_and_b32 s52, s52, 15
    buffer_load_dwordx4 v12, s[36:39], s54 offen offset:0 lds
    buffer_load_dwordx4 v13, s[36:39], s54 offen offset:1024 lds
    buffer_load_dwordx4 v14, s[36:39], s54 offen offset:2048 lds
    buffer_load_dwordx4 v15, s[36:39], s54 offen offset:3072 lds
    s_add_u32 s55, s55, 24576
    s_cmp_ge_u32 s55, 147456
    s_cselect_b32 s55, 0, s55
    s_lshl_b32 s53, s52, 7
    s_add_u32 s53, s53, s56
    s_lshl_b32 s54, s52, 17
    s_add_u32 s54, s54, s57
    s_add_u32 m0, s55, s61
    s_add_u32 s52, s52, 1
    buffer_load_dwordx4 v10, s[32:35], s53 offen offset:0 lds
    buffer_load_dwordx4 v11, s[32:35], s53 offen offset:1024 lds
    s_add_u32 m0, s55, s62
    s_and_b32 s52, s52, 15
    buffer_load_dwordx4 v12, s[36:39], s54 offen offset:0 lds
    buffer_load_dwordx4 v13, s[36:39], s54 offen offset:1024 lds
    buffer_load_dwordx4 v14, s[36:39], s54 offen offset:2048 lds
    buffer_load_dwordx4 v15, s[36:39], s54 offen offset:3072 lds
    s_add_u32 s55, s55, 24576
    s_cmp_ge_u32 s55, 147456
    s_cselect_b32 s55, 0, s55
    s_lshl_b32 s53, s52, 7
    s_add_u32 s53, s53, s56
    s_lshl_b32 s54, s52, 17
    s_add_u32 s54, s54, s57
    s_add_u32 m0, s55, s61
    s_add_u32 s52, s52, 1
    buffer_load_dwordx4 v10, s[32:35], s53 offen offset:0 lds
    buffer_load_dwordx4 v11, s[32:35], s53 offen offset:1024 lds
    s_add_u32 m0, s55, s62
    s_and_b32 s52, s52, 15
    buffer_load_dwordx4 v12, s[36:39], s54 offen offset:0 lds
    buffer_load_dwordx4 v13, s[36:39], s54 offen offset:1024 lds
    buffer_load_dwordx4 v14, s[36:39], s54 offen offset:2048 lds
    buffer_load_dwordx4 v15, s[36:39], s54 offen offset:3072 lds
    s_add_u32 s55, s55, 24576
    s_cmp_ge_u32 s55, 147456
    s_cselect_b32 s55, 0, s55
    s_mov_b32 s58, 0
mha_k2_kernel_ploop:
    s_waitcnt vmcnt(24)
    s_barrier
    s_lshl_b32 s53, s52, 7
    s_add_u32 s53, s53, s56
    s_lshl_b32 s54, s52, 17
    s_add_u32 s54, s54, s57
    s_add_u32 m0, s55, s61
    s_add_u32 s52, s52, 1
    buffer_load_dwordx4 v10, s[32:35], s53 offen offset:0 lds
    buffer_load_dwordx4 v11, s[32:35], s53 offen offset:1024 lds
    s_add_u32 m0, s55, s62
    s_and_b32 s52, s52, 15
    buffer_load_dwordx4 v12, s[36:39], s54 offen offset:0 lds
    buffer_load_dwordx4 v13, s[36:39], s54 offen offset:1024 lds
    buffer_load_dwordx4 v14, s[36:39], s54 offen offset:2048 lds
    buffer_load_dwordx4 v15, s[36:39], s54 offen offset:3072 lds
    s_add_u32 s55, s55, 24576
    s_cmp_ge_u32 s55, 147456
    s_cselect_b32 s55, 0, s55
    s_add_u32 s58, s58, 1
    s_cmp_lt_u32 s58, 11
    s_cbranch_scc1 mha_k2_kernel_ploop
    s_waitcnt vmcnt(24)
    s_barrier
    s_waitcnt vmcnt(18)
    s_barrier
    s_waitcnt vmcnt(12)
    s_barrier
    s_waitcnt vmcnt(6)
    s_barrier
    s_waitcnt vmcnt(0)
    s_barrier
mha_k2_kernel_end:
    s_endpgm
.section .rodata,"a"
.p2align 6
.amdhsa_kernel mha_k1_kernel
  .amdhsa_next_free_vgpr 248
  .amdhsa_next_free_sgpr 102
  .amdhsa_accum_offset 248
  .amdhsa_group_segment_fixed_size 0
  .amdhsa_kernarg_size 64
  .amdhsa_user_sgpr_count 2
  .amdhsa_user_sgpr_kernarg_segment_ptr 1
  .amdhsa_system_sgpr_workgroup_id_x 1
.end_amdhsa_kernel
.section .rodata,"a"
.p2align 6
.amdhsa_kernel mha_k2_kernel
  .amdhsa_next_free_vgpr 152
  .amdhsa_next_free_sgpr 102
  .amdhsa_accum_offset 152
  .amdhsa_group_segment_fixed_size 0
  .amdhsa_kernarg_size 64
  .amdhsa_user_sgpr_count 2
  .amdhsa_user_sgpr_kernarg_segment_ptr 1
  .amdhsa_system_sgpr_workgroup_id_x 1
.end_amdhsa_kernel
```
